```python
import torch

def _softmax(x, axis=-1):
    return torch.softmax(x, dim=axis)
def _gelu(x):
    return torch.nn.functional.gelu(x, approximate="tanh")
def _silu(x):
    return torch.nn.functional.silu(x)
def _sigmoid(x):
    return torch.sigmoid(x)
def _layernorm(x, axis=-1, eps=1e-5):
    m = x.mean(dim=axis, keepdim=True)
    v = x.var(dim=axis, keepdim=True, unbiased=False)
    return (x - m) / torch.sqrt(v + eps)
def _scatter_add(tgt, idx, src, axis=0):
    return tgt.clone().index_add_(axis, idx, src)
def _segment_sum(src, seg, n):
    out = torch.zeros((n,) + src.shape[1:], dtype=src.dtype)
    return out.index_add_(0, seg, src)
def _pad(x, pw):
    flat = tuple(v for pair in reversed(pw) for v in pair)
    return torch.nn.functional.pad(x, flat)

kernel_name = 'parallel_sum__sliding_block_cached__glu_gated_bilinear__decode'

def setup_inputs():

    _w = (lambda a: (lambda t: t.to(torch.bfloat16) if t.is_floating_point() else t)(torch.as_tensor(a)))
    def _A_setup():
        B, Sq, D = 1, 1, 512
        Hq, Hkv, Sk, Dh = 32, 8, 65536, 128
        assert Hq % Hkv == 0, (Hq, Hkv)
        return {
            "x": _w((lambda *s: torch.randn(*s, dtype=torch.bfloat16) * 0.05)(B, Sq, D)),
            "k_cache": _w((lambda *s: torch.randn(*s, dtype=torch.bfloat16) * 1.6)(B, Hkv, Sk, Dh)),
            "v_cache": _w((lambda *s: torch.randn(*s, dtype=torch.bfloat16) * 0.8)(B, Hkv, Sk, Dh)),
            "wq": _w((lambda *s: torch.randn(*s, dtype=torch.bfloat16) * 1.6)(D, Hq * Dh) * (D ** -0.5)),
            "wo": _w((lambda *s: torch.randn(*s, dtype=torch.bfloat16) * 0.8)(Hq * Dh, D) * ((Hq * Dh) ** -0.5)),
        }
    _A_in = _A_setup()

    def _B_setup():
        B, S, D, F = 1, 1, 512, 1792
        return {
            "x": _w((lambda *s: torch.randn(*s, dtype=torch.bfloat16) * 0.05)(B, S, D)),
            "w_gate": _w((lambda *s: torch.randn(*s, dtype=torch.bfloat16) * 0.4)(D, F) * (D ** -0.5)),
            "w_up": _w((lambda *s: torch.randn(*s, dtype=torch.bfloat16) * 0.4)(D, F) * (D ** -0.5)),
            "w_down": _w((lambda *s: torch.randn(*s, dtype=torch.bfloat16) * 0.4)(F, D) * (F ** -0.5)),
        }
    _B_in = _B_setup()

    return {
        "A_x": _A_in["x"],
        "A_k_cache": _A_in["k_cache"],
        "A_v_cache": _A_in["v_cache"],
        "A_wq": _A_in["wq"],
        "A_wo": _A_in["wo"],
        "B_x": _B_in["x"],
        "B_w_gate": _B_in["w_gate"],
        "B_w_up": _B_in["w_up"],
        "B_w_down": _B_in["w_down"],
    }

def reference(A_x, A_k_cache, A_v_cache, A_wq, A_wo, B_x, B_w_gate, B_w_up, B_w_down):
    def _A_ref(x, k_cache, v_cache, wq, wo):
        B, Sq, D = x.shape
        Hq, Dh = 32, 128
        Hkv, Sk = k_cache.shape[1], k_cache.shape[2]
        W = min(4096, max(256, Sk // 4))
        rep = Hq // Hkv
        q = (lambda x, *d: x.permute(*d))((x @ wq).reshape(B, Sq, Hq, Dh), 0, 2, 1, 3)
        k = (lambda x, n, axis: torch.repeat_interleave(x, n, dim=axis))(k_cache[:, :, Sk - W:, :], rep, axis=1)
        v = (lambda x, n, axis: torch.repeat_interleave(x, n, dim=axis))(v_cache[:, :, Sk - W:, :], rep, axis=1)
        scores = torch.einsum("bhqd,bhkd->bhqk", q, k) * (Dh ** -0.5)
        p = _softmax(scores, axis=-1)
        o = torch.einsum("bhqk,bhkd->bhqd", p, v)
        return (lambda x, *d: x.permute(*d))(o, 0, 2, 1, 3).reshape(B, Sq, Hq * Dh) @ wo

    def _B_ref(x, w_gate, w_up, w_down):
        g = torch.einsum("bsd,df->bsf", x, w_gate)
        u = torch.einsum("bsd,df->bsf", x, w_up)
        h = g * u
        return torch.einsum("bsf,fd->bsd", h, w_down)

    x = A_x
    xn = _layernorm(x, axis=-1)
    return x + _A_ref(xn, A_k_cache, A_v_cache, A_wq, A_wo) + _B_ref(xn, B_w_gate, B_w_up, B_w_down)
```

```asm
; @launch grid=(256,1,1) block=(384,1,1) lds=73984
.amdgcn_target "amdgcn-amd-amdhsa--gfx950"
.text
.globl parallel_sum__sliding_block_cached__glu_gated_bilinear__decode_kernel
.p2align 12
.type parallel_sum__sliding_block_cached__glu_gated_bilinear__decode_kernel,@function
parallel_sum__sliding_block_cached__glu_gated_bilinear__decode_kernel:
    s_cmp_ge_u32 s2, 256
    s_cbranch_scc1 L_end
    s_load_dwordx2 s[52:53], s[0:1], 24
    s_load_dwordx2 s[40:41], s[0:1], 0
    s_load_dwordx2 s[76:77], s[0:1], 88
    s_load_dwordx2 s[44:45], s[0:1], 8
    v_lshrrev_b32 v2, 6, v0
    v_and_b32 v1, 63, v0
    s_and_b32 s4, s2, 7
    v_readfirstlane_b32 s3, v2
    s_lshr_b32 s5, s2, 3
    s_lshr_b32 s7, s5, 3
    s_and_b32 s10, s5, 7
    s_mov_b32 s54, 4194304
    s_mov_b32 s55, 0x20000
    s_mov_b32 s42, 1024
    s_mov_b32 s43, s55
    s_mov_b32 s78, 2097152
    s_mov_b32 s79, s55
    s_mov_b32 s46, 134217728
    s_mov_b32 s47, s55
    s_mov_b32 s93, 0x3fb8aa3b
    s_mov_b32 s94, 0x3db504f3
    s_mov_b32 s95, 0xffffff00
    s_mov_b32 s96, 0x0c0c0400
    s_mov_b32 s97, 0x04000c0c
    s_mov_b32 s98, 0x07060500
    s_mov_b32 s99, 0x07060501
    s_mov_b32 s100, 0x07060502
    s_mov_b32 s101, 0x07060503
    s_cmp_ge_u32 s3, 4
    s_cbranch_scc1 L_comm0
    s_lshl_b32 s12, s7, 20
    s_lshl_b32 s11, s3, 18
    s_add_u32 s12, s12, s11
    s_lshl_b32 s11, s4, 10
    s_add_u32 s12, s12, s11
    s_lshl_b32 s11, s10, 7
    s_add_u32 s12, s12, s11
    v_lshlrev_b32 v163, 4, v1
    v_lshrrev_b32 v164, 3, v1
    v_and_b32 v4, 0x70, v163
    v_lshl_add_u32 v6, v164, 13, v4
    v_mov_b32 v7, 0
    s_add_u32 s13, s12, 65536
    s_add_u32 s14, s12, 131072
    s_add_u32 s15, s12, 196608
    v_lshrrev_b32 v2, 4, v1
    v_and_b32 v3, 15, v1
    v_xor_b32 v5, v2, v3
    v_lshlrev_b32 v5, 4, v5
    v_lshl_add_u32 v156, v2, 8, v5
    v_xor_b32 v157, 64, v156
    v_xor_b32 v158, 128, v156
    v_xor_b32 v159, 192, v156
    s_lshl_b32 s19, s4, 24
    s_lshl_b32 s11, s5, 15
    s_add_u32 s19, s19, s11
    s_lshl_b32 s20, s3, 13
    s_add_u32 s19, s19, s20
    s_add_u32 s19, s19, 15728640
    s_and_b32 s25, s4, 1
    s_lshl_b32 s25, s25, 12
    s_xor_b32 s26, s25, 4096
    s_add_u32 s27, s19, s26
    s_add_u32 s19, s19, s25
    s_add_u32 s25, s25, s20
    s_add_u32 s26, s26, s20
    s_mov_b32 m0, s25
    s_waitcnt lgkmcnt(0)
    s_cmp_lg_u32 s3, 0
    s_cbranch_scc1 L_nox
    buffer_load_dwordx4 v[8:11], v163, s[40:43], 0 offen
L_nox:
    buffer_load_dwordx4 v[12:15], v6, s[52:55], s12 offen nt
    buffer_load_dwordx4 v[16:19], v6, s[52:55], s13 offen nt
    buffer_load_dwordx4 v[20:23], v6, s[52:55], s14 offen nt
    buffer_load_dwordx4 v[24:27], v6, s[52:55], s15 offen nt
    buffer_load_dword v167, v7, s[76:79], 0 offen
    s_load_dwordx2 s[48:49], s[0:1], 16
    s_load_dwordx2 s[60:61], s[0:1], 48
    s_load_dwordx2 s[64:65], s[0:1], 56
    s_load_dwordx2 s[56:57], s[0:1], 32
    s_load_dwordx2 s[68:69], s[0:1], 64
    buffer_load_dwordx4 v156, s[44:47], s19 offen offset:0 nt lds
    buffer_load_dwordx4 v157, s[44:47], s19 offen offset:1024 nt lds
    buffer_load_dwordx4 v158, s[44:47], s19 offen offset:2048 nt lds
    buffer_load_dwordx4 v159, s[44:47], s19 offen offset:3072 nt lds
    s_mov_b32 m0, s26
    s_nop 0
    buffer_load_dwordx4 v156, s[44:47], s27 offen offset:0 nt lds
    buffer_load_dwordx4 v157, s[44:47], s27 offen offset:1024 nt lds
    buffer_load_dwordx4 v158, s[44:47], s27 offen offset:2048 nt lds
    buffer_load_dwordx4 v159, s[44:47], s27 offen offset:3072 nt lds
    v_mul_u32_u24 v162, 3584, v164
    v_add_u32 v161, v162, v4
    s_lshl_b32 s8, s7, 3
    s_add_u32 s8, s8, s4
    s_cmp_lt_u32 s8, 28
    s_cselect_b32 s9, 1835008, 0
    s_mov_b32 s50, s46
    s_mov_b32 s51, s55
    s_mov_b32 s58, s54
    s_mov_b32 s59, s55
    s_mov_b32 s62, s9
    s_mov_b32 s63, s55
    s_mov_b32 s66, s9
    s_mov_b32 s67, s55
    s_mov_b32 s70, s9
    s_mov_b32 s71, s55
    s_branch L_cmp_go
L_comm0:
    s_cmp_eq_u32 s3, 5
    s_cbranch_scc0 L_nocodepf
    s_getpc_b64 s[12:13]
L_pc:
    s_sub_u32 s12, s12, L_pc-parallel_sum__sliding_block_cached__glu_gated_bilinear__decode_kernel
    s_subb_u32 s13, s13, 0
    s_lshl_b32 s14, s5, 6
    s_add_u32 s12, s12, s14
    s_addc_u32 s13, s13, 0
    s_load_dword s32, s[12:13], 0
    s_load_dword s33, s[12:13], 2048
    s_load_dword s34, s[12:13], 4096
    s_add_u32 s15, s14, 6144
    s_min_u32 s15, s15, L_end-parallel_sum__sliding_block_cached__glu_gated_bilinear__decode_kernel
    s_sub_u32 s15, s15, s14
    s_load_dword s35, s[12:13], s15
L_nocodepf:
    s_setprio 3
    s_branch L_comm
L_cmp_go:
    s_mov_b32 s80, 0x3030303
    s_mov_b32 s81, s80
    s_mov_b32 s82, 0xc0c0c0c
    s_mov_b32 s83, s82
    s_mov_b32 s84, 0x30303030
    s_mov_b32 s85, s84
    s_mov_b32 s86, 0xc0c0c0c0
    s_mov_b32 s87, s86
    v_and_b32 v166, 1, v1
    v_lshlrev_b32 v166, 4, v166
    s_lshl_b32 s17, s10, 6
    s_lshl_b32 s11, s3, 4
    s_add_u32 s17, s17, s11
    s_mul_i32 s17, s17, 3584
    s_lshl_b32 s11, s8, 7
    s_add_u32 s17, s17, s11
    s_lshl_b32 s21, s4, 19
    s_lshr_b32 s11, s5, 2
    s_lshl_b32 s12, s11, 16
    s_add_u32 s21, s21, s12
    s_lshl_b32 s12, s3, 14
    s_add_u32 s21, s21, s12
    s_and_b32 s23, s5, 3
    s_lshl_b32 s23, s23, 8
    s_add_u32 s21, s21, s23
    s_lshl_b32 s22, s8, 16
    s_and_b32 s11, s11, 1
    s_lshl_b32 s11, s11, 15
    s_add_u32 s22, s22, s11
    s_lshl_b32 s12, s3, 13
    s_add_u32 s22, s22, s12
    s_add_u32 s22, s22, s23
    v_lshlrev_b32 v162, 4, v3
    v_lshl_add_u32 v162, v2, 10, v162
    v_lshrrev_b32 v105, 3, v3
    v_lshl_add_u32 v105, v2, 1, v105
    s_lshl_b32 s11, s7, 7
    s_lshl_b32 s12, s3, 5
    s_add_u32 s11, s11, s12
    s_lshl_b32 s11, s11, 1
    s_add_u32 s11, s11, 65536
    v_lshl_add_u32 v106, v105, 1, s11
    s_lshl_b32 s11, s10, 6
    s_lshl_b32 s12, s3, 4
    s_add_u32 s11, s11, s12
    s_lshl_b32 s11, s11, 1
    s_add_u32 s11, s11, 65536
    v_lshl_add_u32 v107, v105, 1, s11
    s_cmp_lg_u32 s3, 0
    s_cbranch_scc1 L_noln
    s_waitcnt vmcnt(13)
    v_lshlrev_b32 v80, 16, v8
    v_and_b32 v81, 0xffff0000, v8
    v_lshlrev_b32 v82, 16, v9
    v_and_b32 v83, 0xffff0000, v9
    v_lshlrev_b32 v84, 16, v10
    v_and_b32 v85, 0xffff0000, v10
    v_lshlrev_b32 v86, 16, v11
    v_and_b32 v87, 0xffff0000, v11
    v_add_f32 v88, v80, v81
    v_add_f32 v89, v82, v83
    v_add_f32 v90, v84, v85
    v_add_f32 v91, v86, v87
    v_add_f32 v88, v88, v89
    v_add_f32 v90, v90, v91
    v_add_f32 v88, v88, v90
    s_nop 1
    v_add_f32_dpp v88, v88, v88 quad_perm:[1,0,3,2] row_mask:0xf bank_mask:0xf
    s_nop 1
    v_add_f32_dpp v88, v88, v88 quad_perm:[2,3,0,1] row_mask:0xf bank_mask:0xf
    s_nop 1
    v_add_f32_dpp v88, v88, v88 row_half_mirror row_mask:0xf bank_mask:0xf
    s_nop 1
    v_add_f32_dpp v88, v88, v88 row_mirror row_mask:0xf bank_mask:0xf
    v_mov_b32 v89, v88
    s_nop 1
    v_permlane16_swap_b32 v89, v88
    s_nop 0
    v_add_f32 v88, v89, v88
    v_mov_b32 v89, v88
    s_nop 1
    v_permlane32_swap_b32 v89, v88
    s_nop 0
    v_add_f32 v88, v89, v88
    v_mul_f32 v88, 0x3b000000, v88
    v_sub_f32 v92, v80, v88
    v_sub_f32 v93, v81, v88
    v_sub_f32 v94, v82, v88
    v_sub_f32 v95, v83, v88
    v_sub_f32 v96, v84, v88
    v_sub_f32 v97, v85, v88
    v_sub_f32 v98, v86, v88
    v_sub_f32 v99, v87, v88
    v_mul_f32 v90, v92, v92
    v_fmac_f32 v90, v93, v93
    v_fmac_f32 v90, v94, v94
    v_fmac_f32 v90, v95, v95
    v_fmac_f32 v90, v96, v96
    v_fmac_f32 v90, v97, v97
    v_fmac_f32 v90, v98, v98
    v_fmac_f32 v90, v99, v99
    s_nop 1
    v_add_f32_dpp v90, v90, v90 quad_perm:[1,0,3,2] row_mask:0xf bank_mask:0xf
    s_nop 1
    v_add_f32_dpp v90, v90, v90 quad_perm:[2,3,0,1] row_mask:0xf bank_mask:0xf
    s_nop 1
    v_add_f32_dpp v90, v90, v90 row_half_mirror row_mask:0xf bank_mask:0xf
    s_nop 1
    v_add_f32_dpp v90, v90, v90 row_mirror row_mask:0xf bank_mask:0xf
    v_mov_b32 v89, v90
    s_nop 1
    v_permlane16_swap_b32 v89, v90
    s_nop 0
    v_add_f32 v90, v89, v90
    v_mov_b32 v89, v90
    s_nop 1
    v_permlane32_swap_b32 v89, v90
    s_nop 0
    v_add_f32 v90, v89, v90
    v_mul_f32 v90, 0x3b000000, v90
    v_cvt_pk_bf16_f32 v88, v88, v90
    v_and_b32 v90, 0xffff0000, v88
    v_lshlrev_b32 v88, 16, v88
    v_add_f32 v90, 0x3727c5ac, v90
    v_cvt_pk_bf16_f32 v90, v90, v90
    v_lshlrev_b32 v90, 16, v90
    v_sqrt_f32 v90, v90
    v_sub_f32 v92, v80, v88
    v_sub_f32 v93, v81, v88
    v_sub_f32 v94, v82, v88
    v_sub_f32 v95, v83, v88
    v_sub_f32 v96, v84, v88
    v_sub_f32 v97, v85, v88
    v_sub_f32 v98, v86, v88
    v_sub_f32 v99, v87, v88
    v_cvt_pk_bf16_f32 v90, v90, v90
    v_lshlrev_b32 v90, 16, v90
    v_rcp_f32 v90, v90
    v_cvt_pk_bf16_f32 v100, v92, v93
    v_cvt_pk_bf16_f32 v101, v94, v95
    v_cvt_pk_bf16_f32 v102, v96, v97
    v_cvt_pk_bf16_f32 v103, v98, v99
    v_lshlrev_b32 v92, 16, v100
    v_and_b32 v93, 0xffff0000, v100
    v_lshlrev_b32 v94, 16, v101
    v_and_b32 v95, 0xffff0000, v101
    v_lshlrev_b32 v96, 16, v102
    v_and_b32 v97, 0xffff0000, v102
    v_lshlrev_b32 v98, 16, v103
    v_and_b32 v99, 0xffff0000, v103
    v_mul_f32 v92, v92, v90
    v_mul_f32 v93, v93, v90
    v_mul_f32 v94, v94, v90
    v_mul_f32 v95, v95, v90
    v_mul_f32 v96, v96, v90
    v_mul_f32 v97, v97, v90
    v_mul_f32 v98, v98, v90
    v_mul_f32 v99, v99, v90
    v_cvt_pk_bf16_f32 v100, v92, v93
    v_cvt_pk_bf16_f32 v101, v94, v95
    v_cvt_pk_bf16_f32 v102, v96, v97
    v_cvt_pk_bf16_f32 v103, v98, v99
    v_add_u32 v104, 65536, v163
    ds_write_b128 v104, v[100:103]
L_noln:
    s_waitcnt lgkmcnt(0)
    s_barrier
    s_waitcnt lgkmcnt(0)
    ds_read_u16 v80, v106 offset:0
    ds_read_u16 v81, v106 offset:16
    ds_read_u16 v82, v106 offset:32
    ds_read_u16 v83, v106 offset:48
    ds_read_u16 v84, v107 offset:0
    ds_read_u16 v85, v107 offset:16
    s_waitcnt lgkmcnt(0)
    v_lshlrev_b32 v86, v166, v80
    v_cndmask_b32_e64 v48, 0, v86, s[80:81]
    v_cndmask_b32_e64 v49, 0, v86, s[82:83]
    v_cndmask_b32_e64 v50, 0, v86, s[84:85]
    v_cndmask_b32_e64 v51, 0, v86, s[86:87]
    v_lshlrev_b32 v86, v166, v81
    v_cndmask_b32_e64 v52, 0, v86, s[80:81]
    v_cndmask_b32_e64 v53, 0, v86, s[82:83]
    v_cndmask_b32_e64 v54, 0, v86, s[84:85]
    v_cndmask_b32_e64 v55, 0, v86, s[86:87]
    v_lshlrev_b32 v86, v166, v82
    v_cndmask_b32_e64 v56, 0, v86, s[80:81]
    v_cndmask_b32_e64 v57, 0, v86, s[82:83]
    v_cndmask_b32_e64 v58, 0, v86, s[84:85]
    v_cndmask_b32_e64 v59, 0, v86, s[86:87]
    v_lshlrev_b32 v86, v166, v83
    v_cndmask_b32_e64 v60, 0, v86, s[80:81]
    v_cndmask_b32_e64 v61, 0, v86, s[82:83]
    v_cndmask_b32_e64 v62, 0, v86, s[84:85]
    v_cndmask_b32_e64 v63, 0, v86, s[86:87]
    v_lshlrev_b32 v86, v166, v84
    v_cndmask_b32_e64 v64, 0, v86, s[80:81]
    v_cndmask_b32_e64 v65, 0, v86, s[82:83]
    v_cndmask_b32_e64 v66, 0, v86, s[84:85]
    v_cndmask_b32_e64 v67, 0, v86, s[86:87]
    v_lshlrev_b32 v86, v166, v85
    v_cndmask_b32_e64 v68, 0, v86, s[80:81]
    v_cndmask_b32_e64 v69, 0, v86, s[82:83]
    v_cndmask_b32_e64 v70, 0, v86, s[84:85]
    v_cndmask_b32_e64 v71, 0, v86, s[86:87]
    v_lshlrev_b32 v86, 1, v2
    v_xor_b32 v86, v86, v3
    v_lshlrev_b32 v86, 4, v86
    v_lshl_add_u32 v160, v2, 8, v86
    v_xor_b32 v164, 128, v160
    v_lshrrev_b32 v87, 5, v1
    v_lshlrev_b32 v87, 8, v87
    v_and_b32 v86, 7, v1
    v_lshl_add_u32 v87, v86, 5, v87
    v_and_b32 v86, 1, v2
    v_lshl_add_u32 v87, v86, 4, v87
    s_lshl_b32 s11, s3, 9
    s_add_u32 s11, s11, 66560
    v_add_u32 v163, s11, v87
    s_waitcnt vmcnt(8)
    v_add_u32 v167, 0x01010101, v167
    v_mfma_f32_16x16x32_bf16 v[72:75], v[48:51], v[12:15], 0
    v_mfma_f32_16x16x32_bf16 v[72:75], v[52:55], v[16:19], v[72:75]
    v_mfma_f32_16x16x32_bf16 v[72:75], v[56:59], v[20:23], v[72:75]
    v_mfma_f32_16x16x32_bf16 v[72:75], v[60:63], v[24:27], v[72:75]
    s_mov_b32 exec_lo, 0x00ff00ff
    s_mov_b32 exec_hi, 0xff00ff00
    s_nop 5
    ds_write_b128 v163, v[72:75]
    s_mov_b64 exec, -1
    v_readfirstlane_b32 s6, v167
    s_waitcnt lgkmcnt(0)
    s_barrier
    s_cmp_lg_u32 s3, 3
    s_cbranch_scc1 L_pub1_done
    v_lshlrev_b32 v86, 4, v3
    v_add_u32 v87, 66560, v86
    ds_read_b128 v[112:115], v87 offset:0
    ds_read_b128 v[116:119], v87 offset:256
    ds_read_b128 v[120:123], v87 offset:512
    ds_read_b128 v[124:127], v87 offset:768
    ds_read_b128 v[128:131], v87 offset:1024
    ds_read_b128 v[132:135], v87 offset:1280
    ds_read_b128 v[136:139], v87 offset:1536
    ds_read_b128 v[140:143], v87 offset:1792
    s_lshl_b32 s11, s4, 2
    s_add_u32 s11, s11, s7
    s_lshl_b32 s11, s11, 11
    s_lshl_b32 s12, s10, 8
    s_add_u32 s11, s11, s12
    s_add_u32 s11, s11, 4096
    v_add_u32 v86, s11, v86
    s_lshl_b32 s12, s4, 9
    s_lshl_b32 s13, s5, 4
    s_add_u32 s12, s12, s13
    s_add_u32 s12, s12, 69632
    v_mov_b32 v87, s12
    v_cmp_eq_u32 vcc, 0, v2
    s_getreg_b32 s13, hwreg(HW_REG_XCC_ID, 0, 4)
    s_lshl_b32 s13, s13, 8
    v_cndmask_b32 v86, v87, v86, vcc
    s_waitcnt lgkmcnt(0)
    v_add_f32 v112, v112, v116
    v_add_f32 v120, v120, v124
    v_add_f32 v128, v128, v132
    v_add_f32 v136, v136, v140
    v_add_f32 v113, v113, v117
    v_add_f32 v121, v121, v125
    v_add_f32 v129, v129, v133
    v_add_f32 v137, v137, v141
    v_add_f32 v114, v114, v118
    v_add_f32 v122, v122, v126
    v_add_f32 v130, v130, v134
    v_add_f32 v138, v138, v142
    v_add_f32 v115, v115, v119
    v_add_f32 v123, v123, v127
    v_add_f32 v131, v131, v135
    v_add_f32 v139, v139, v143
    v_add_f32 v112, v112, v120
    v_add_f32 v128, v128, v136
    v_add_f32 v113, v113, v121
    v_add_f32 v129, v129, v137
    v_add_f32 v114, v114, v122
    v_add_f32 v130, v130, v138
    v_add_f32 v115, v115, v123
    v_add_f32 v131, v131, v139
    v_add_f32 v112, v112, v128
    v_add_f32 v113, v113, v129
    v_add_f32 v114, v114, v130
    v_add_f32 v115, v115, v131
    v_mov_b32 v116, s13
    v_cndmask_b32 v112, v116, v112, vcc
    v_perm_b32 v112, v112, v167, s98
    v_perm_b32 v113, v113, v167, s99
    v_perm_b32 v114, v114, v167, s100
    v_perm_b32 v115, v115, v167, s101
    s_mov_b32 exec_lo, 0x0001ffff
    s_mov_b32 exec_hi, 0
    buffer_store_dwordx4 v[112:115], v86, s[76:79], 0 offen
    s_mov_b32 s12, 69632
    buffer_store_dwordx4 v[112:115], v86, s[76:79], s12 offen sc1
    s_mov_b64 exec, -1
L_pub1_done:
    s_barrier
    s_add_u32 s18, s17, 28672
    buffer_load_dwordx4 v[8:11], v161, s[60:63], s17 offen nt
    buffer_load_dwordx4 v[12:15], v161, s[60:63], s18 offen nt
    buffer_load_dwordx4 v[16:19], v161, s[64:67], s17 offen nt
    buffer_load_dwordx4 v[20:23], v161, s[64:67], s18 offen nt
    s_add_u32 m0, s25, 32768
    s_nop 0
    buffer_load_dwordx4 v160, s[48:51], s19 offen offset:0 nt lds
    buffer_load_dwordx4 v164, s[48:51], s19 offen offset:1024 nt lds
    buffer_load_dwordx4 v160, s[48:51], s19 offen offset:2048 nt lds
    s_cmp_eq_u32 s3, 3
    s_cbranch_scc1 L_nokwait
    s_waitcnt vmcnt(6)
L_nokwait:
    s_barrier
    v_and_b32 v85, 1, v2
    v_lshrrev_b32 v86, 1, v2
    v_lshl_or_b32 v85, v85, 1, v86
    v_lshlrev_b32 v86, 4, v3
    v_lshl_add_u32 v161, v85, 10, v86
    v_xor_b32 v86, v2, v3
    v_lshlrev_b32 v86, 4, v86
    v_lshl_add_u32 v156, v3, 8, v86
    v_add_u32 v156, s20, v156
    v_xor_b32 v157, 64, v156
    v_xor_b32 v158, 128, v156
    v_xor_b32 v159, 192, v156
    v_and_b32 v86, 3, v1
    v_mul_u32_u24 v86, 272, v86
    v_lshl_add_u32 v4, v2, 4, v86
    v_add_u32 v4, 72704, v4
    s_add_u32 m0, s25, 32768
    s_nop 0
    buffer_load_dwordx4 v164, s[48:51], s19 offen offset:3072 nt lds
    s_add_u32 m0, s26, 32768
    s_nop 0
    buffer_load_dwordx4 v160, s[48:51], s27 offen offset:0 nt lds
    buffer_load_dwordx4 v164, s[48:51], s27 offen offset:1024 nt lds
    buffer_load_dwordx4 v160, s[48:51], s27 offen offset:2048 nt lds
    buffer_load_dwordx4 v164, s[48:51], s27 offen offset:3072 nt lds
    s_add_u32 s38, s4, s3
    s_and_b32 s38, s38, 3
    s_add_u32 s11, s38, 0
    s_and_b32 s11, s11, 3
    s_lshl_b32 s11, s11, 12
    s_add_u32 s32, s21, s11
    s_add_u32 s11, s38, 1
    s_and_b32 s11, s11, 3
    s_lshl_b32 s11, s11, 12
    s_add_u32 s33, s21, s11
    s_add_u32 s11, s38, 2
    s_and_b32 s11, s11, 3
    s_lshl_b32 s11, s11, 12
    s_add_u32 s34, s21, s11
    s_add_u32 s11, s38, 3
    s_and_b32 s11, s11, 3
    s_lshl_b32 s11, s11, 12
    s_add_u32 s35, s21, s11
    s_and_b32 s11, s38, 1
    s_lshl_b32 s11, s11, 12
    s_add_u32 s36, s22, s11
    s_xor_b32 s11, s11, 4096
    s_add_u32 s37, s22, s11
    v_lshrrev_b32 v84, 2, v3
    v_lshl_add_u32 v85, v2, 2, v84
    v_and_b32 v84, 7, v85
    v_lshlrev_b32 v85, 8, v85
    v_lshl_add_u32 v85, v84, 5, v85
    v_and_b32 v84, 3, v3
    v_lshl_add_u32 v85, v84, 3, v85
    v_add_u32 v85, 32768, v85
    s_lshl_b32 s11, s3, 6
    v_xor_b32 v48, s11, v85
    v_xor_b32 v49, 32, v48
    v_and_b32 v84, 3, v3
    v_lshlrev_b32 v84, 14, v84
    v_bfe_u32 v85, v3, 2, 1
    v_lshl_add_u32 v84, v85, 11, v84
    v_lshl_add_u32 v84, v2, 4, v84
    s_lshl_b32 s11, s4, 16
    s_lshl_b32 s12, s3, 12
    s_add_u32 s11, s11, s12
    s_lshl_b32 s12, s5, 6
    s_add_u32 s11, s11, s12
    s_add_u32 s11, s11, 294912
    v_add_u32 v50, s11, v84
    s_lshr_b32 s14, s5, 3
    s_lshl_b32 s11, s4, 2
    s_add_u32 s11, s11, s14
    s_lshl_b32 s12, s11, 9
    s_add_u32 s12, s12, 274432
    v_lshrrev_b32 v84, 2, v1
    v_lshl_add_u32 v52, v84, 4, s12
    s_bfe_u32 s12, s5, 0x10002
    s_lshl_b32 s11, s11, 3
    s_lshl_b32 s13, s12, 2
    s_add_u32 s11, s11, s13
    s_add_u32 s11, s11, s3
    s_lshl_b32 s11, s11, 11
    s_add_u32 s11, s11, 294912
    v_add_u32 v84, s38, v1
    v_and_b32 v84, 3, v84
    v_and_b32 v85, 0x3c, v1
    v_or_b32 v84, v84, v85
    v_lshl_add_u32 v51, v84, 4, s11
    s_lshl_b32 s11, s4, 2
    s_add_u32 s11, s11, s14
    s_lshl_b32 s11, s11, 12
    s_lshl_b32 s12, s12, 7
    s_add_u32 s11, s11, s12
    s_lshl_b32 s12, s3, 5
    s_add_u32 s11, s11, s12
    s_add_u32 s11, s11, 143360
    v_bfe_u32 v84, v1, 2, 3
    v_lshlrev_b32 v84, 9, v84
    v_bfe_u32 v85, v1, 1, 1
    v_lshl_add_u32 v84, v85, 8, v84
    v_xor_b32 v85, s38, v1
    v_and_b32 v85, 1, v85
    v_lshl_add_u32 v84, v85, 4, v84
    v_add_u32 v53, s11, v84
    v_mul_u32_u24 v54, 0x020202, v2
    v_lshlrev_b32 v84, 25, v2
    v_add_u32 v54, v54, v84
    v_add_u32 v54, 0x01000100, v54
    v_and_b32 v84, 1, v1
    v_mov_b32 v85, 0xffff
    v_lshlrev_b32 v84, 4, v84
    v_lshlrev_b32 v84, v84, v85
    v_cndmask_b32_e64 v136, 0, v84, s[80:81]
    v_cndmask_b32_e64 v137, 0, v84, s[82:83]
    v_cndmask_b32_e64 v138, 0, v84, s[84:85]
    v_cndmask_b32_e64 v139, 0, v84, s[86:87]
    v_and_b32 v84, 3, v1
    s_lshl_b32 s11, s3, 2
    s_add_u32 s11, s11, 73824
    v_lshl_add_u32 v55, v84, 4, s11
    v_lshlrev_b32 v84, 4, v84
    v_add_u32 v56, 73824, v84
    v_lshlrev_b32 v84, 4, v1
    s_lshl_b32 s11, s3, 10
    s_add_u32 s11, s11, 66560
    v_add_u32 v57, s11, v84
    v_add_u32 v58, 66560, v84
    v_lshrrev_b32 v60, 2, v1
    v_lshlrev_b32 v60, 12, v60
    v_and_b32 v61, 3, v1
    v_lshl_add_u32 v60, v61, 4, v60
    s_and_b32 s11, s5, 3
    s_lshl_b32 s11, s11, 15
    s_lshl_b32 s12, s4, 3
    s_lshr_b32 s13, s5, 2
    s_add_u32 s12, s12, s13
    s_lshl_b32 s12, s12, 6
    s_add_u32 s11, s11, s12
    s_add_u32 s11, s11, 819200
    v_add_u32 v60, s11, v60
    v_lshlrev_b32 v62, 4, v1
    v_add_u32 v62, 70656, v62
    v_lshlrev_b32 v85, 5, v3
    v_lshl_add_u32 v85, v2, 4, v85
    s_lshl_b32 s11, s3, 9
    s_add_u32 s11, s11, 70656
    v_add_u32 v59, s11, v85
    s_waitcnt vmcnt(8)
    v_mfma_f32_16x16x32_bf16 v[72:75], v[64:67], v[8:11], 0
    v_mfma_f32_16x16x32_bf16 v[72:75], v[68:71], v[12:15], v[72:75]
    v_mfma_f32_16x16x32_bf16 v[76:79], v[64:67], v[16:19], 0
    v_mfma_f32_16x16x32_bf16 v[76:79], v[68:71], v[20:23], v[76:79]
    s_nop 6
    s_mov_b32 exec_lo, 0x00ff00ff
    s_mov_b32 exec_hi, 0xff00ff00
    ds_write_b128 v163, v[72:75] offset:2048
    ds_write_b128 v163, v[76:79] offset:4096
    s_mov_b64 exec, -1
    s_waitcnt lgkmcnt(0)
    s_barrier
    ds_read_b128 v[112:115], v4 offset:0
    ds_read_b128 v[116:119], v4 offset:64
    ds_read_b128 v[120:123], v4 offset:128
    ds_read_b128 v[124:127], v4 offset:192
    ds_read_b128 v[80:83], v156 offset:0
    ds_read_b128 v[84:87], v157 offset:0
    ds_read_b128 v[88:91], v158 offset:0
    ds_read_b128 v[92:95], v159 offset:0
    ds_read_b128 v[96:99], v156 offset:4096
    ds_read_b128 v[100:103], v157 offset:4096
    ds_read_b128 v[104:107], v158 offset:4096
    ds_read_b128 v[108:111], v159 offset:4096
    v_mov_b32 v6, 73808
    ds_read_b32 v7, v6
    s_waitcnt lgkmcnt(8)
    v_mfma_f32_16x16x32_bf16 v[144:147], v[80:83], v[112:115], 0
    s_waitcnt lgkmcnt(7)
    v_mfma_f32_16x16x32_bf16 v[144:147], v[84:87], v[116:119], v[144:147]
    s_waitcnt lgkmcnt(6)
    v_mfma_f32_16x16x32_bf16 v[144:147], v[88:91], v[120:123], v[144:147]
    s_waitcnt lgkmcnt(5)
    v_mfma_f32_16x16x32_bf16 v[144:147], v[92:95], v[124:127], v[144:147]
    s_waitcnt lgkmcnt(4)
    v_mfma_f32_16x16x32_bf16 v[148:151], v[96:99], v[112:115], 0
    s_waitcnt lgkmcnt(3)
    v_mfma_f32_16x16x32_bf16 v[148:151], v[100:103], v[116:119], v[148:151]
    s_waitcnt lgkmcnt(2)
    v_mfma_f32_16x16x32_bf16 v[148:151], v[104:107], v[120:123], v[148:151]
    s_waitcnt lgkmcnt(1)
    v_mfma_f32_16x16x32_bf16 v[148:151], v[108:111], v[124:127], v[148:151]
    buffer_load_dwordx4 v[24:27], v161, s[56:59], s32 offen nt
    buffer_load_dwordx4 v[28:31], v161, s[56:59], s33 offen nt
    s_nop 4
    s_waitcnt lgkmcnt(0)
    v_readfirstlane_b32 s24, v7
    v_cvt_pk_bf16_f32 v152, v144, v145
    v_cvt_pk_bf16_f32 v153, v146, v147
    v_cvt_pk_bf16_f32 v154, v148, v149
    v_cvt_pk_bf16_f32 v155, v150, v151
    v_lshlrev_b32 v144, 16, v152
    v_and_b32 v145, 0xffff0000, v152
    v_lshlrev_b32 v146, 16, v153
    v_and_b32 v147, 0xffff0000, v153
    v_lshlrev_b32 v148, 16, v154
    v_and_b32 v149, 0xffff0000, v154
    v_lshlrev_b32 v150, 16, v155
    v_and_b32 v151, 0xffff0000, v155
    v_mul_f32 v144, s94, v144
    v_mul_f32 v145, s94, v145
    v_mul_f32 v146, s94, v146
    v_mul_f32 v147, s94, v147
    v_mul_f32 v148, s94, v148
    v_mul_f32 v149, s94, v149
    v_mul_f32 v150, s94, v150
    v_mul_f32 v151, s94, v151
    v_cvt_pk_bf16_f32 v152, v144, v145
    v_cvt_pk_bf16_f32 v153, v146, v147
    v_cvt_pk_bf16_f32 v154, v148, v149
    v_cvt_pk_bf16_f32 v155, v150, v151
    v_lshlrev_b32 v144, 16, v152
    v_and_b32 v145, 0xffff0000, v152
    v_lshlrev_b32 v146, 16, v153
    v_and_b32 v147, 0xffff0000, v153
    v_lshlrev_b32 v148, 16, v154
    v_and_b32 v149, 0xffff0000, v154
    v_lshlrev_b32 v150, 16, v155
    v_and_b32 v151, 0xffff0000, v155
    v_max3_f32 v82, v144, v145, v146
    v_max3_f32 v83, v147, v148, v149
    v_max3_f32 v82, v82, v150, v151
    v_max_f32 v82, v82, v83
    v_mov_b32 v83, v82
    s_nop 1
    v_permlane16_swap_b32 v83, v82
    s_nop 0
    v_max_f32 v82, v83, v82
    v_mov_b32 v83, v82
    s_nop 1
    v_permlane32_swap_b32 v83, v82
    s_nop 0
    v_max_f32 v82, v83, v82
    s_mov_b64 exec, 15
    ds_write_b32 v55, v82
    s_mov_b64 exec, -1
    buffer_load_dwordx4 v[32:35], v161, s[56:59], s34 offen nt
    buffer_load_dwordx4 v[36:39], v161, s[56:59], s35 offen nt
    s_waitcnt lgkmcnt(0)
    s_barrier
    buffer_load_dwordx4 v[40:43], v162, s[68:71], s36 offen nt
    buffer_load_dwordx4 v[44:47], v162, s[68:71], s37 offen nt
    ds_read_b128 v[84:87], v56
    s_waitcnt lgkmcnt(0)
    v_max3_f32 v82, v84, v85, v86
    v_max_f32 v82, v82, v87
    v_mul_f32 v83, s93, v82
    v_fma_f32 v144, v144, s93, -v83
    v_fma_f32 v145, v145, s93, -v83
    v_fma_f32 v146, v146, s93, -v83
    v_fma_f32 v147, v147, s93, -v83
    v_fma_f32 v148, v148, s93, -v83
    v_fma_f32 v149, v149, s93, -v83
    v_fma_f32 v150, v150, s93, -v83
    v_fma_f32 v151, v151, s93, -v83
    v_exp_f32 v144, v144
    v_exp_f32 v145, v145
    v_exp_f32 v146, v146
    v_exp_f32 v147, v147
    v_exp_f32 v148, v148
    v_exp_f32 v149, v149
    v_exp_f32 v150, v150
    v_exp_f32 v151, v151
    s_nop 0
    v_cvt_pk_bf16_f32 v152, v144, v145
    v_cvt_pk_bf16_f32 v153, v146, v147
    v_cvt_pk_bf16_f32 v154, v148, v149
    v_cvt_pk_bf16_f32 v155, v150, v151
    v_add_f32 v84, v144, v145
    v_add_f32 v85, v146, v147
    ds_write_b128 v57, v[152:155]
    v_add_f32 v86, v148, v149
    v_add_f32 v87, v150, v151
    v_add_f32 v84, v84, v85
    v_add_f32 v86, v86, v87
    v_add_f32 v84, v84, v86
    v_mov_b32 v85, v84
    s_nop 1
    v_permlane16_swap_b32 v85, v84
    s_nop 0
    v_add_f32 v84, v85, v84
    v_mov_b32 v85, v84
    s_nop 1
    v_permlane32_swap_b32 v85, v84
    s_nop 0
    v_add_f32 v84, v85, v84
    s_mov_b64 exec, 15
    ds_write_b32 v55, v84 offset:64
    s_mov_b64 exec, -1
    s_waitcnt vmcnt(6) lgkmcnt(0)
    s_barrier
    ds_read_b128 v[112:115], v58 offset:0
    ds_read_b64_tr_b16 v[80:81], v48 offset:0
    ds_read_b64_tr_b16 v[82:83], v48 offset:4096
    ds_read_b64_tr_b16 v[84:85], v49 offset:0
    ds_read_b64_tr_b16 v[86:87], v49 offset:4096
    ds_read_b128 v[116:119], v58 offset:1024
    ds_read_b64_tr_b16 v[88:89], v48 offset:8192
    ds_read_b64_tr_b16 v[90:91], v48 offset:12288
    ds_read_b64_tr_b16 v[92:93], v49 offset:8192
    ds_read_b64_tr_b16 v[94:95], v49 offset:12288
    ds_read_b128 v[120:123], v58 offset:2048
    ds_read_b64_tr_b16 v[96:97], v48 offset:16384
    ds_read_b64_tr_b16 v[98:99], v48 offset:20480
    ds_read_b64_tr_b16 v[100:101], v49 offset:16384
    ds_read_b64_tr_b16 v[102:103], v49 offset:20480
    ds_read_b128 v[124:127], v58 offset:3072
    ds_read_b64_tr_b16 v[104:105], v48 offset:24576
    ds_read_b64_tr_b16 v[106:107], v48 offset:28672
    ds_read_b64_tr_b16 v[108:109], v49 offset:24576
    ds_read_b64_tr_b16 v[110:111], v49 offset:28672
    s_waitcnt lgkmcnt(15)
    v_mfma_f32_16x16x32_bf16 v[128:131], v[80:83], v[112:115], 0
    s_waitcnt lgkmcnt(15)
    v_mfma_f32_16x16x32_bf16 v[132:135], v[84:87], v[112:115], 0
    s_waitcnt lgkmcnt(12)
    v_mfma_f32_16x16x32_bf16 v[128:131], v[88:91], v[116:119], v[128:131]
    s_waitcnt lgkmcnt(10)
    v_mfma_f32_16x16x32_bf16 v[132:135], v[92:95], v[116:119], v[132:135]
    s_waitcnt lgkmcnt(7)
    v_mfma_f32_16x16x32_bf16 v[128:131], v[96:99], v[120:123], v[128:131]
    s_waitcnt lgkmcnt(5)
    v_mfma_f32_16x16x32_bf16 v[132:135], v[100:103], v[120:123], v[132:135]
    s_waitcnt lgkmcnt(2)
    v_mfma_f32_16x16x32_bf16 v[128:131], v[104:107], v[124:127], v[128:131]
    s_waitcnt lgkmcnt(0)
    v_mfma_f32_16x16x32_bf16 v[132:135], v[108:111], v[124:127], v[132:135]
    s_mov_b32 s12, 0x00f000f0
    s_mov_b32 s13, 0x00f000f0
    s_mov_b32 exec_lo, 0x00ff00ff
    s_mov_b32 exec_hi, 0x00ff00ff
    s_nop 3
    v_cndmask_b32_e64 v128, v128, v132, s[12:13]
    v_cndmask_b32_e64 v129, v129, v133, s[12:13]
    v_cndmask_b32_e64 v130, v130, v134, s[12:13]
    v_cndmask_b32_e64 v131, v131, v135, s[12:13]
    v_perm_b32 v128, v128, v167, s98
    v_perm_b32 v129, v129, v167, s99
    v_perm_b32 v130, v130, v167, s100
    v_perm_b32 v131, v131, v167, s101
    s_cmp_eq_u32 s24, 1
    s_cbranch_scc0 L_opub_slow
    buffer_store_dwordx4 v[128:131], v50, s[76:79], 0 offen
    s_branch L_opub_done
L_opub_slow:
    buffer_store_dwordx4 v[128:131], v50, s[76:79], 0 offen sc1
L_opub_done:
    s_mov_b64 exec, -1
    s_mov_b32 s92, 0
L_ogat:
    buffer_load_dwordx4 v[80:83], v52, s[76:79], 0 offen sc1
    buffer_load_dwordx4 v[84:87], v52, s[76:79], 0 offen offset:256 sc1
    buffer_load_dwordx4 v[96:99], v53, s[76:79], 0 offen sc1
    buffer_load_dwordx4 v[88:91], v51, s[76:79], 0 offen sc1
    buffer_load_dwordx4 v[92:95], v51, s[76:79], 0 offen offset:1024 sc1
    s_waitcnt vmcnt(0)
    v_perm_b32 v100, v81, v80, s96
    v_perm_b32 v101, v83, v82, s97
    v_or_b32 v100, v100, v101
    v_cmp_ne_u32 s[88:89], s6, v100
    v_perm_b32 v100, v85, v84, s96
    v_perm_b32 v101, v87, v86, s97
    v_or_b32 v100, v100, v101
    v_cmp_ne_u32 s[90:91], s6, v100
    s_or_b64 s[88:89], s[88:89], s[90:91]
    v_perm_b32 v100, v89, v88, s96
    v_perm_b32 v101, v91, v90, s97
    v_or_b32 v100, v100, v101
    v_cmp_ne_u32 s[90:91], s6, v100
    s_or_b64 s[88:89], s[88:89], s[90:91]
    v_perm_b32 v100, v93, v92, s96
    v_perm_b32 v101, v95, v94, s97
    v_or_b32 v100, v100, v101
    v_cmp_ne_u32 s[90:91], s6, v100
    s_or_b64 s[88:89], s[88:89], s[90:91]
    v_perm_b32 v100, v97, v96, s96
    v_perm_b32 v101, v99, v98, s97
    v_or_b32 v100, v100, v101
    v_cmp_ne_u32 s[90:91], s6, v100
    s_or_b64 s[88:89], s[88:89], s[90:91]
    s_cmp_eq_u64 s[88:89], 0
    s_cbranch_scc1 L_ook
    s_add_u32 s92, s92, 1
    s_cmp_le_u32 s92, 200000
    s_cbranch_scc1 L_ogat
L_ook:
    v_and_b32 v80, s95, v80
    v_and_b32 v84, s95, v84
    v_max_f32 v100, v80, v84
    v_add_f32_dpp v96, v96, v96 row_ror:8 row_mask:0xf bank_mask:0xf
    v_add_f32_dpp v97, v97, v97 row_ror:8 row_mask:0xf bank_mask:0xf
    v_add_f32_dpp v98, v98, v98 row_ror:8 row_mask:0xf bank_mask:0xf
    v_add_f32_dpp v99, v99, v99 row_ror:8 row_mask:0xf bank_mask:0xf
    v_max_f32_dpp v100, v100, v100 row_ror:8 row_mask:0xf bank_mask:0xf
    v_add_f32_dpp v96, v96, v96 row_ror:4 row_mask:0xf bank_mask:0xf
    v_add_f32_dpp v97, v97, v97 row_ror:4 row_mask:0xf bank_mask:0xf
    v_add_f32_dpp v98, v98, v98 row_ror:4 row_mask:0xf bank_mask:0xf
    v_add_f32_dpp v99, v99, v99 row_ror:4 row_mask:0xf bank_mask:0xf
    v_max_f32_dpp v100, v100, v100 row_ror:4 row_mask:0xf bank_mask:0xf
    v_mov_b32 v104, v96
    v_mov_b32 v105, v97
    v_mov_b32 v106, v98
    v_mov_b32 v107, v99
    v_mov_b32 v101, v100
    v_permlane16_swap_b32 v104, v96
    v_permlane16_swap_b32 v105, v97
    v_permlane16_swap_b32 v106, v98
    v_permlane16_swap_b32 v107, v99
    v_permlane16_swap_b32 v101, v100
    v_add_f32 v96, v104, v96
    v_add_f32 v97, v105, v97
    v_add_f32 v98, v106, v98
    v_add_f32 v99, v107, v99
    v_max_f32 v100, v101, v100
    v_cvt_pk_bf16_f32 v104, v96, v97
    v_mov_b32 v101, v100
    v_cvt_pk_bf16_f32 v105, v98, v99
    v_lshlrev_b32 v96, 16, v104
    v_permlane32_swap_b32 v101, v100
    v_and_b32 v97, 0xffff0000, v104
    v_max_f32 v100, v101, v100
    v_lshlrev_b32 v98, 16, v105
    v_and_b32 v99, 0xffff0000, v105
    v_sub_f32 v80, v80, v100
    v_sub_f32 v84, v84, v100
    v_mul_f32 v80, s93, v80
    v_mul_f32 v84, s93, v84
    v_exp_f32 v80, v80
    v_exp_f32 v84, v84
    v_mul_f32_dpp v104, v96, v96 quad_perm:[2,3,0,1] row_mask:0xf bank_mask:0xf
    v_mul_f32_dpp v105, v97, v97 quad_perm:[2,3,0,1] row_mask:0xf bank_mask:0xf
    v_mul_f32_dpp v106, v98, v98 quad_perm:[2,3,0,1] row_mask:0xf bank_mask:0xf
    v_mul_f32_dpp v107, v99, v99 quad_perm:[2,3,0,1] row_mask:0xf bank_mask:0xf
    v_mul_f32 v102, v80, v81
    v_fmac_f32 v102, v84, v85
    v_mul_f32 v88, v80, v88
    v_mul_f32 v89, v80, v89
    v_mul_f32 v90, v80, v90
    v_mul_f32 v91, v80, v91
    v_fmac_f32 v88, v84, v92
    v_fmac_f32 v89, v84, v93
    v_fmac_f32 v90, v84, v94
    v_fmac_f32 v91, v84, v95
    v_cvt_pk_bf16_f32 v96, v104, v105
    v_cvt_pk_bf16_f32 v97, v106, v107
    v_permlane32_swap_b32 v88, v89
    v_permlane32_swap_b32 v90, v91
    v_perm_b32 v98, v97, v96, v54
    v_add_f32 v88, v88, v89
    v_add_f32 v90, v90, v91
    v_mov_b32 v103, v102
    v_and_b32_dpp v64, v98, v136 quad_perm:[0,0,0,0] row_mask:0xf bank_mask:0xf
    v_and_b32_dpp v65, v98, v137 quad_perm:[0,0,0,0] row_mask:0xf bank_mask:0xf
    v_and_b32_dpp v66, v98, v138 quad_perm:[0,0,0,0] row_mask:0xf bank_mask:0xf
    v_and_b32_dpp v67, v98, v139 quad_perm:[0,0,0,0] row_mask:0xf bank_mask:0xf
    v_permlane16_swap_b32 v88, v90
    v_permlane16_swap_b32 v103, v102
    v_and_b32_dpp v68, v98, v136 quad_perm:[1,1,1,1] row_mask:0xf bank_mask:0xf
    v_and_b32_dpp v69, v98, v137 quad_perm:[1,1,1,1] row_mask:0xf bank_mask:0xf
    v_and_b32_dpp v70, v98, v138 quad_perm:[1,1,1,1] row_mask:0xf bank_mask:0xf
    v_and_b32_dpp v71, v98, v139 quad_perm:[1,1,1,1] row_mask:0xf bank_mask:0xf
    v_add_f32 v88, v88, v90
    v_add_f32 v102, v103, v102
    v_mfma_f32_16x16x32_bf16 v[72:75], v[64:67], v[40:43], 0
    v_mov_b32 v103, v102
    v_add_f32_dpp v88, v88, v88 row_ror:8 row_mask:0xf bank_mask:0xf
    v_mfma_f32_16x16x32_bf16 v[72:75], v[68:71], v[44:47], v[72:75]
    v_permlane32_swap_b32 v103, v102
    v_add_f32_dpp v88, v88, v88 row_ror:4 row_mask:0xf bank_mask:0xf
    v_add_f32 v102, v103, v102
    s_nop 1
    v_add_f32_dpp v102, v102, v102 row_ror:8 row_mask:0xf bank_mask:0xf
    s_nop 1
    v_add_f32_dpp v102, v102, v102 row_ror:4 row_mask:0xf bank_mask:0xf
    s_nop 0
    v_rcp_f32 v102, v102
    s_nop 0
    v_mul_f32 v88, v88, v102
    v_cvt_pk_bf16_f32 v88, v88, v88
    s_nop 1
    v_and_b32_dpp v112, v88, v136 quad_perm:[0,0,0,0] row_mask:0xf bank_mask:0xf
    v_and_b32_dpp v113, v88, v137 quad_perm:[0,0,0,0] row_mask:0xf bank_mask:0xf
    v_and_b32_dpp v114, v88, v138 quad_perm:[0,0,0,0] row_mask:0xf bank_mask:0xf
    v_and_b32_dpp v115, v88, v139 quad_perm:[0,0,0,0] row_mask:0xf bank_mask:0xf
    v_and_b32_dpp v116, v88, v136 quad_perm:[1,1,1,1] row_mask:0xf bank_mask:0xf
    v_and_b32_dpp v117, v88, v137 quad_perm:[1,1,1,1] row_mask:0xf bank_mask:0xf
    v_and_b32_dpp v118, v88, v138 quad_perm:[1,1,1,1] row_mask:0xf bank_mask:0xf
    v_and_b32_dpp v119, v88, v139 quad_perm:[1,1,1,1] row_mask:0xf bank_mask:0xf
    v_mfma_f32_16x16x32_bf16 v[72:75], v[112:115], v[24:27], v[72:75]
    v_and_b32_dpp v120, v88, v136 quad_perm:[2,2,2,2] row_mask:0xf bank_mask:0xf
    v_and_b32_dpp v121, v88, v137 quad_perm:[2,2,2,2] row_mask:0xf bank_mask:0xf
    v_and_b32_dpp v122, v88, v138 quad_perm:[2,2,2,2] row_mask:0xf bank_mask:0xf
    v_and_b32_dpp v123, v88, v139 quad_perm:[2,2,2,2] row_mask:0xf bank_mask:0xf
    v_mfma_f32_16x16x32_bf16 v[72:75], v[116:119], v[28:31], v[72:75]
    v_and_b32_dpp v124, v88, v136 quad_perm:[3,3,3,3] row_mask:0xf bank_mask:0xf
    v_and_b32_dpp v125, v88, v137 quad_perm:[3,3,3,3] row_mask:0xf bank_mask:0xf
    v_and_b32_dpp v126, v88, v138 quad_perm:[3,3,3,3] row_mask:0xf bank_mask:0xf
    v_and_b32_dpp v127, v88, v139 quad_perm:[3,3,3,3] row_mask:0xf bank_mask:0xf
    v_mfma_f32_16x16x32_bf16 v[72:75], v[120:123], v[32:35], v[72:75]
    s_nop 0
    v_mfma_f32_16x16x32_bf16 v[72:75], v[124:127], v[36:39], v[72:75]
    s_mov_b32 exec_hi, 0
    s_nop 6
    ds_write_b128 v59, v[72:75]
    s_mov_b64 exec, -1
    s_waitcnt lgkmcnt(0)
    s_barrier
    s_cmp_lg_u32 s3, 0
    s_cbranch_scc1 L_cmp_end
    ds_read_b128 v[88:91], v62 offset:0
    ds_read_b128 v[92:95], v62 offset:512
    ds_read_b128 v[96:99], v62 offset:1024
    ds_read_b128 v[100:103], v62 offset:1536
    s_waitcnt lgkmcnt(2)
    v_add_f32 v88, v88, v92
    v_add_f32 v89, v89, v93
    v_add_f32 v90, v90, v94
    v_add_f32 v91, v91, v95
    s_waitcnt lgkmcnt(0)
    v_add_f32 v96, v96, v100
    v_add_f32 v97, v97, v101
    v_add_f32 v98, v98, v102
    v_add_f32 v99, v99, v103
    v_add_f32 v88, v88, v96
    v_add_f32 v89, v89, v97
    v_add_f32 v90, v90, v98
    v_add_f32 v91, v91, v99
    v_perm_b32 v88, v88, v167, s98
    v_perm_b32 v89, v89, v167, s99
    v_perm_b32 v90, v90, v167, s100
    v_perm_b32 v91, v91, v167, s101
    s_mov_b32 exec_hi, 0
    buffer_store_dwordx4 v[88:91], v60, s[76:79], 0 offen sc1
    s_mov_b64 exec, -1
L_cmp_end:
    s_branch L_done
L_comm:
    s_load_dwordx2 s[72:73], s[0:1], 72
    s_mov_b32 s74, s42
    s_mov_b32 s75, s55
    s_lshl_b32 s8, s7, 3
    s_add_u32 s8, s8, s4
    v_lshrrev_b32 v2, 4, v1
    v_and_b32 v3, 15, v1
    v_mov_b32 v4, 0
    s_lshl_b32 s11, s4, 13
    s_sub_u32 s12, s3, 4
    s_lshl_b32 s12, s12, 10
    s_add_u32 s11, s11, s12
    s_add_u32 s11, s11, 4096
    v_lshlrev_b32 v6, 4, v1
    v_add_u32 v6, s11, v6
    s_lshl_b32 s11, s4, 9
    s_add_u32 s11, s11, 69632
    v_and_b32 v7, 31, v1
    v_lshl_add_u32 v7, v7, 4, s11
    s_sub_u32 s12, s3, 4
    s_lshl_b32 s12, s12, 1
    v_lshrrev_b32 v8, 5, v1
    v_add_u32 v8, s12, v8
    v_mul_u32_u24 v8, 272, v8
    v_and_b32 v9, 31, v1
    v_lshl_add_u32 v8, v9, 3, v8
    v_add_u32 v8, 72704, v8
    s_barrier
    s_barrier
    s_barrier
    s_waitcnt lgkmcnt(0)
    buffer_load_dword v5, v4, s[76:79], 0 offen
    s_mov_b32 s92, 0
    s_mov_b32 s14, 0
    s_barrier
L_qgat:
    s_add_u32 s15, s14, 4096
    buffer_load_dwordx4 v[16:19], v6, s[76:79], s14 offen sc1
    buffer_load_dwordx4 v[20:23], v6, s[76:79], s14 offen offset:2048 sc1
    buffer_load_dwordx4 v[24:27], v6, s[76:79], s15 offen sc1
    buffer_load_dwordx4 v[28:31], v6, s[76:79], s15 offen offset:2048 sc1
    buffer_load_dwordx4 v[32:35], v7, s[76:79], s14 offen sc1
    s_waitcnt vmcnt(0)
    v_add_u32 v9, 0x01010101, v5
    s_nop 0
    v_readfirstlane_b32 s6, v9
    v_perm_b32 v36, v17, v16, s96
    v_perm_b32 v37, v19, v18, s97
    v_or_b32 v36, v36, v37
    v_cmp_ne_u32 s[88:89], s6, v36
    v_perm_b32 v36, v21, v20, s96
    v_perm_b32 v37, v23, v22, s97
    v_or_b32 v36, v36, v37
    v_cmp_ne_u32 s[90:91], s6, v36
    s_or_b64 s[88:89], s[88:89], s[90:91]
    v_perm_b32 v36, v25, v24, s96
    v_perm_b32 v37, v27, v26, s97
    v_or_b32 v36, v36, v37
    v_cmp_ne_u32 s[90:91], s6, v36
    s_or_b64 s[88:89], s[88:89], s[90:91]
    v_perm_b32 v36, v29, v28, s96
    v_perm_b32 v37, v31, v30, s97
    v_or_b32 v36, v36, v37
    v_cmp_ne_u32 s[90:91], s6, v36
    s_or_b64 s[88:89], s[88:89], s[90:91]
    v_perm_b32 v36, v33, v32, s96
    v_perm_b32 v37, v35, v34, s97
    v_or_b32 v36, v36, v37
    v_cmp_ne_u32 s[90:91], s6, v36
    s_or_b64 s[88:89], s[88:89], s[90:91]
    s_cmp_eq_u64 s[88:89], 0
    s_cbranch_scc1 L_qok
    s_add_u32 s92, s92, 1
    s_cmp_eq_u32 s92, 24
    s_cselect_b32 s14, 69632, s14
    s_cmp_le_u32 s92, 200000
    s_cbranch_scc1 L_qgat
L_qok:
    v_and_b32 v16, s95, v16
    v_and_b32 v17, s95, v17
    v_and_b32 v18, s95, v18
    v_and_b32 v19, s95, v19
    v_and_b32 v20, s95, v20
    v_and_b32 v21, s95, v21
    v_and_b32 v22, s95, v22
    v_and_b32 v23, s95, v23
    v_and_b32 v24, s95, v24
    v_and_b32 v25, s95, v25
    v_and_b32 v26, s95, v26
    v_and_b32 v27, s95, v27
    v_and_b32 v28, s95, v28
    v_and_b32 v29, s95, v29
    v_and_b32 v30, s95, v30
    v_and_b32 v31, s95, v31
    v_add_f32 v16, v16, v20
    v_add_f32 v24, v24, v28
    v_add_f32 v17, v17, v21
    v_add_f32 v25, v25, v29
    v_add_f32 v18, v18, v22
    v_add_f32 v26, v26, v30
    v_add_f32 v19, v19, v23
    v_add_f32 v27, v27, v31
    v_add_f32 v16, v16, v24
    v_add_f32 v17, v17, v25
    v_add_f32 v18, v18, v26
    v_add_f32 v19, v19, v27
    v_cvt_pk_bf16_f32 v16, v16, v17
    v_cvt_pk_bf16_f32 v17, v18, v19
    ds_write_b64 v8, v[16:17]
    s_getreg_b32 s13, hwreg(HW_REG_XCC_ID, 0, 4)
    v_bfe_u32 v32, v32, 8, 8
    v_cmp_ne_u32 vcc, s13, v32
    s_cmp_eq_u64 vcc, 0
    s_cselect_b32 s13, 1, 0
    s_mov_b32 s24, s13
    v_mov_b32 v33, s13
    v_mov_b32 v34, 73808
    s_cmp_eq_u32 s3, 5
    s_cbranch_scc0 L_nomode
    ds_write_b32 v34, v33
L_nomode:
    s_waitcnt lgkmcnt(0)
    s_barrier
    s_lshl_b32 s11, s2, 12
    s_add_u32 s11, s11, 819200
    v_lshl_add_u32 v60, v1, 4, s11
    v_and_b32 v61, 1, v2
    v_lshrrev_b32 v62, 1, v2
    v_lshl_or_b32 v61, v61, 1, v62
    v_and_b32 v62, 3, v1
    v_lshl_add_u32 v61, v62, 2, v61
    s_and_b32 s11, s2, 31
    s_lshl_b32 s11, s11, 4
    v_add_u32 v61, s11, v61
    v_lshlrev_b32 v61, 1, v61
    s_cmp_eq_u32 s3, 5
    s_cbranch_scc1 L_comm5
    buffer_load_ushort v62, v61, s[40:43], 0 offen
    s_lshl_b32 s11, s2, 9
    s_add_u32 s11, s11, 819200
    v_lshl_add_u32 v10, v1, 7, s11
    s_mov_b64 exec, 15
    buffer_load_dword v11, v10, s[76:79], 0 offen
    s_mov_b64 exec, -1
    s_barrier
    s_barrier
    s_barrier
L_final:
    s_cmp_ge_u32 s2, 32
    s_cbranch_scc1 L_done
    s_mov_b32 s92, 0
L_fgat:
    buffer_load_dwordx4 v[16:19], v60, s[76:79], 0 offen offset:0 sc1
    buffer_load_dwordx4 v[20:23], v60, s[76:79], 0 offen offset:1024 sc1
    buffer_load_dwordx4 v[24:27], v60, s[76:79], 0 offen offset:2048 sc1
    buffer_load_dwordx4 v[28:31], v60, s[76:79], 0 offen offset:3072 sc1
    s_waitcnt vmcnt(0)
    v_perm_b32 v36, v17, v16, s96
    v_perm_b32 v37, v19, v18, s97
    v_or_b32 v36, v36, v37
    v_cmp_ne_u32 s[88:89], s6, v36
    v_perm_b32 v36, v21, v20, s96
    v_perm_b32 v37, v23, v22, s97
    v_or_b32 v36, v36, v37
    v_cmp_ne_u32 s[90:91], s6, v36
    s_or_b64 s[88:89], s[88:89], s[90:91]
    v_perm_b32 v36, v25, v24, s96
    v_perm_b32 v37, v27, v26, s97
    v_or_b32 v36, v36, v37
    v_cmp_ne_u32 s[90:91], s6, v36
    s_or_b64 s[88:89], s[88:89], s[90:91]
    v_perm_b32 v36, v29, v28, s96
    v_perm_b32 v37, v31, v30, s97
    v_or_b32 v36, v36, v37
    v_cmp_ne_u32 s[90:91], s6, v36
    s_or_b64 s[88:89], s[88:89], s[90:91]
    s_cmp_eq_u64 s[88:89], 0
    s_cbranch_scc1 L_fok
    s_add_u32 s92, s92, 1
    s_cmp_le_u32 s92, 200000
    s_cbranch_scc1 L_fgat
L_fok:
    v_add_f32 v16, v16, v20
    v_add_f32 v24, v24, v28
    v_add_f32 v17, v17, v21
    v_add_f32 v25, v25, v29
    v_add_f32 v18, v18, v22
    v_add_f32 v26, v26, v30
    v_add_f32 v19, v19, v23
    v_add_f32 v27, v27, v31
    v_add_f32 v16, v16, v24
    v_add_f32 v17, v17, v25
    v_add_f32 v18, v18, v26
    v_add_f32 v19, v19, v27
    s_nop 0
    v_permlane32_swap_b32 v16, v17
    v_permlane32_swap_b32 v18, v19
    s_nop 0
    v_add_f32 v16, v16, v17
    v_add_f32 v18, v18, v19
    s_nop 1
    v_permlane16_swap_b32 v16, v18
    s_nop 0
    v_add_f32 v16, v16, v18
    v_lshlrev_b32 v62, 16, v62
    s_nop 0
    v_add_f32_dpp v16, v16, v16 row_ror:8 row_mask:0xf bank_mask:0xf
    s_nop 1
    v_add_f32_dpp v16, v16, v16 row_ror:4 row_mask:0xf bank_mask:0xf
    v_add_f32 v16, v16, v62
    v_cvt_pk_bf16_f32 v16, v16, v16
    s_mov_b32 exec_lo, 0x000f000f
    s_mov_b32 exec_hi, 0x000f000f
    buffer_store_short v16, v61, s[72:75], 0 offen
    s_cmp_lg_u32 s2, 0
    s_cbranch_scc1 L_noepoch
    s_mov_b64 exec, 1
    v_mov_b32 v17, 0
    v_mov_b32 v18, s6
    buffer_store_dword v18, v17, s[76:79], 0 offen
L_noepoch:
    s_mov_b64 exec, -1
    s_branch L_done
L_comm5:
    v_mov_b32 v167, s6
    v_lshlrev_b32 v6, 4, v3
    v_and_b32 v7, 1, v2
    v_lshl_add_u32 v7, v7, 11, v6
    v_add_u32 v7, 68608, v7
    ds_read_b128 v[16:19], v7 offset:0
    ds_read_b128 v[20:23], v7 offset:256
    ds_read_b128 v[24:27], v7 offset:512
    ds_read_b128 v[28:31], v7 offset:768
    ds_read_b128 v[32:35], v7 offset:1024
    ds_read_b128 v[36:39], v7 offset:1280
    ds_read_b128 v[40:43], v7 offset:1536
    ds_read_b128 v[44:47], v7 offset:1792
    s_lshl_b32 s12, s4, 2
    s_add_u32 s12, s12, s7
    s_lshl_b32 s12, s12, 3
    s_add_u32 s12, s12, s10
    s_lshl_b32 s12, s12, 9
    s_add_u32 s12, s12, 143360
    v_and_b32 v7, 1, v2
    v_lshl_add_u32 v6, v7, 8, v6
    v_add_u32 v6, s12, v6
    s_waitcnt lgkmcnt(0)
    v_add_f32 v16, v16, v20
    v_add_f32 v24, v24, v28
    v_add_f32 v32, v32, v36
    v_add_f32 v40, v40, v44
    v_add_f32 v17, v17, v21
    v_add_f32 v25, v25, v29
    v_add_f32 v33, v33, v37
    v_add_f32 v41, v41, v45
    v_add_f32 v18, v18, v22
    v_add_f32 v26, v26, v30
    v_add_f32 v34, v34, v38
    v_add_f32 v42, v42, v46
    v_add_f32 v19, v19, v23
    v_add_f32 v27, v27, v31
    v_add_f32 v35, v35, v39
    v_add_f32 v43, v43, v47
    v_add_f32 v16, v16, v24
    v_add_f32 v32, v32, v40
    v_add_f32 v17, v17, v25
    v_add_f32 v33, v33, v41
    v_add_f32 v18, v18, v26
    v_add_f32 v34, v34, v42
    v_add_f32 v19, v19, v27
    v_add_f32 v35, v35, v43
    v_add_f32 v16, v16, v32
    v_add_f32 v17, v17, v33
    v_add_f32 v18, v18, v34
    v_add_f32 v19, v19, v35
    v_perm_b32 v16, v16, v167, s98
    v_perm_b32 v17, v17, v167, s99
    v_perm_b32 v18, v18, v167, s100
    v_perm_b32 v19, v19, v167, s101
    s_mov_b32 exec_hi, 0
    s_cmp_eq_u32 s24, 1
    s_cbranch_scc0 L_gupub_slow
    buffer_store_dwordx4 v[16:19], v6, s[76:79], 0 offen
    s_branch L_gupub_done
L_gupub_slow:
    buffer_store_dwordx4 v[16:19], v6, s[76:79], 0 offen sc1
L_gupub_done:
    s_mov_b64 exec, -1
    v_and_b32 v8, 3, v1
    v_lshlrev_b32 v9, 4, v8
    v_add_u32 v9, 73824, v9
    s_lshl_b32 s11, s4, 11
    s_lshl_b32 s12, s5, 4
    s_add_u32 s11, s11, s12
    s_add_u32 s11, s11, 274432
    v_lshl_add_u32 v8, v8, 9, s11
    s_barrier
    s_barrier
    ds_read_b128 v[20:23], v9
    ds_read_b128 v[24:27], v9 offset:64
    s_waitcnt lgkmcnt(0)
    v_max3_f32 v20, v20, v21, v22
    v_add_f32 v24, v24, v25
    v_add_f32 v26, v26, v27
    v_max_f32 v20, v20, v23
    v_add_f32 v21, v24, v26
    v_perm_b32 v20, v20, v167, s98
    v_perm_b32 v21, v21, v167, s99
    v_perm_b32 v22, v22, v167, s100
    v_perm_b32 v23, v23, v167, s101
    s_mov_b64 exec, 15
    s_cmp_eq_u32 s24, 1
    s_cbranch_scc0 L_mlpub_slow
    buffer_store_dwordx4 v[20:23], v8, s[76:79], 0 offen
    s_branch L_mlpub_done
L_mlpub_slow:
    buffer_store_dwordx4 v[20:23], v8, s[76:79], 0 offen sc1
L_mlpub_done:
    s_mov_b64 exec, -1
    s_barrier
L_done:
L_end:
    s_endpgm
.section .rodata,"a"
.p2align 6
.amdhsa_kernel parallel_sum__sliding_block_cached__glu_gated_bilinear__decode_kernel
.amdhsa_next_free_vgpr 168
.amdhsa_next_free_sgpr 102
.amdhsa_accum_offset 168
.amdhsa_group_segment_fixed_size 0
.amdhsa_kernarg_size 96
.amdhsa_user_sgpr_count 2
.amdhsa_user_sgpr_kernarg_segment_ptr 1
.amdhsa_system_sgpr_workgroup_id_x 1
.amdhsa_float_denorm_mode_32 3
.end_amdhsa_kernel
```
